```python
import torch

def _softmax(x, axis=-1):
    return torch.softmax(x, dim=axis)
def _gelu(x):
    return torch.nn.functional.gelu(x, approximate="tanh")
def _silu(x):
    return torch.nn.functional.silu(x)
def _sigmoid(x):
    return torch.sigmoid(x)
def _layernorm(x, axis=-1, eps=1e-5):
    m = x.mean(dim=axis, keepdim=True)
    v = x.var(dim=axis, keepdim=True, unbiased=False)
    return (x - m) / torch.sqrt(v + eps)
def _scatter_add(tgt, idx, src, axis=0):
    return tgt.clone().index_add_(axis, idx, src)
def _segment_sum(src, seg, n):
    out = torch.zeros((n,) + src.shape[1:], dtype=src.dtype)
    return out.index_add_(0, seg, src)
def _pad(x, pw):
    flat = tuple(v for pair in reversed(pw) for v in pair)
    return torch.nn.functional.pad(x, flat)

kernel_name = 'standalone__batchnorm__prompt'

def setup_inputs():

    _w = (lambda a: (lambda t: t.to(torch.bfloat16) if t.is_floating_point() else t)(torch.as_tensor(a)))
    B, S, C = 1, 2048, 640
    K = 3
    return {
        "x": _w((lambda *s: torch.randn(*s, dtype=torch.bfloat16) * 0.05)(B, S, C)),
        "w": _w((lambda *s: torch.randn(*s, dtype=torch.bfloat16) * 0.05)(K, C, C) * (1.0 / (K * C) ** 0.5)),
        "mean": _w((lambda *s: torch.randn(*s, dtype=torch.bfloat16) * 0.05)(C) * 0.1),
        "var": _w(torch.abs((lambda *s: torch.randn(*s, dtype=torch.bfloat16) * 0.05)(C)) + 0.5),
        "g": _w((lambda *s: torch.randn(*s, dtype=torch.bfloat16) * 0.05)(C) + 1.0),
        "b": _w((lambda *s: torch.randn(*s, dtype=torch.bfloat16) * 0.05)(C) * 0.1),
    }

def reference(x, w, mean, var, g, b):
    K = 3
    P = K // 2
    S = x.shape[1]
    xp = _pad(x, ((0, 0), (P, P), (0, 0)))
    y = sum(torch.einsum('bsc,cd->bsd', xp[:, k:k + S, :], w[k]) for k in range(K))
    inv_std = 1.0 / torch.sqrt(var + 1e-5)
    y = (y - mean) * (g * inv_std) + b
    return _silu(y)
```

```asm
; @launch grid=(256,1,1) block=(512,1,1) lds=147968
.amdgcn_target "amdgcn-amd-amdhsa--gfx950"
.text
.globl standalone__batchnorm__prompt_kernel
.p2align 12
.fill 832, 4, 0xbf800000
.p2align 8
.type standalone__batchnorm__prompt_kernel,@function
standalone__batchnorm__prompt_kernel:
s_load_dwordx2 s[8:9], s[0:1], 0
s_load_dwordx2 s[12:13], s[0:1], 8
v_lshrrev_b32 v1, 6, v0
s_and_b32 s20, s2, 7
s_lshr_b32 s21, s2, 3
v_readfirstlane_b32 s3, v1
s_lshr_b32 s22, s20, 1
s_lshl_b32 s26, s22, 3
s_or_b32 s26, s26, 0x80000
s_bfe_u32 s24, 1379343360, s26
s_bfe_u32 s25, 471538460, s26
v_and_b32 v0, 63, v0
s_cmp_ge_u32 s21, s25
s_cbranch_scc1 L_pf
s_add_u32 s24, s24, s21
s_mul_i32 s25, s24, 205
s_lshr_b32 s25, s25, 10
s_mul_i32 s26, s25, 5
s_sub_u32 s26, s24, s26
s_bitcmp1_b32 s20, 0
s_cselect_b32 s27, 5, 0
s_add_u32 s27, s27, s26
s_lshl_b32 s27, s27, 7
s_cmp_lt_u32 s3, 4
s_cbranch_scc1 L_ld
s_cmp_lg_u32 s3, 4
s_cbranch_scc1 L_c1
s_load_dwordx8 s[44:51], s[0:1], 16
v_and_b32 v4, 7, v0
v_lshl_add_u32 v4, v4, 4, s27
s_mov_b32 m0, 147456
s_waitcnt lgkmcnt(0)
v_mov_b32 v2, s44
v_mov_b32 v3, s45
s_lshl_b64 exec, -1, 8
v_mov_b32 v2, s46
v_mov_b32 v3, s47
s_lshl_b64 exec, -1, 16
v_mov_b32 v2, s48
v_mov_b32 v3, s49
s_lshl_b64 exec, -1, 24
v_mov_b32 v2, s50
v_mov_b32 v3, s51
s_mov_b64 exec, 0xffffffff
v_add_co_u32 v2, vcc, v2, v4
s_nop 1
v_addc_co_u32 v3, vcc, 0, v3, vcc
global_load_lds_dwordx4 v[2:3], off
s_mov_b64 exec, -1
L_c1:
s_getpc_b64 s[36:37]
s_and_b32 s36, s36, 0xfffff000
s_lshl_b32 s30, s21, 2
s_add_u32 s30, s30, s3
s_lshl_b32 s30, s30, 6
s_cmp_lt_u32 s30, 1536
s_cselect_b32 s31, 0, 1792
s_add_u32 s30, s30, s31
s_add_u32 s30, s30, 768
s_min_u32 s30, s30, 8128
s_load_dword s38, s[36:37], s30
s_branch L_cons
L_ld:
v_lshrrev_b32 v8, 3, v0
s_lshl_b32 s30, s3, 3
s_and_b32 s31, s3, 2
s_lshl_b32 s31, s31, 1
v_and_b32 v9, 2, v8
v_add_u32 v8, s30, v8
v_xor_b32 v9, v9, v0
v_xor_b32 v9, s31, v9
v_and_b32 v9, 7, v9
s_movk_i32 s31, 1280
v_lshl_add_u32 v9, v9, 4, s27
v_mad_u32_u24 v13, v8, s31, v9
s_add_u32 s56, s25, s26
s_mul_i32 s30, s56, 52
s_lshr_b32 s30, s30, 8
s_mul_i32 s30, s30, 5
s_sub_u32 s56, s56, s30
s_cmp_eq_u32 s56, 1
s_cselect_b32 s32, 128, 0
s_cselect_b32 s33, 81920, 0
s_and_b32 s39, s25, 1
s_mul_i32 s37, s39, 40960
s_sub_u32 s38, 40960, s37
s_add_u32 s34, s33, s38
s_add_u32 s33, s33, s37
s_mov_b32 s14, 2457600
s_mov_b32 s15, 0x20000
s_mov_b32 s10, 2621440
s_mov_b32 s11, 0x20000
s_lshl_b32 s36, s3, 10
s_mov_b32 s35, s36
s_mul_i32 s25, s25, 94
s_add_u32 m0, s35, 12288
s_add_u32 s40, s33, 819200
s_add_u32 s41, s33, 1638400
v_bfe_u32 v1, v0, 2, 3
s_and_b32 s30, s3, 1
s_lshl_b32 s30, s30, 3
v_add_u32 v2, s30, v1
v_lshrrev_b32 v3, 2, v2
v_xor_b32 v3, v3, v0
v_and_b32 v3, 3, v3
v_lshrrev_b32 v4, 5, v0
s_waitcnt lgkmcnt(0)
buffer_load_dwordx4 v13, s[12:15], s33 offen lds
s_add_u32 m0, s35, 20480
s_load_dwordx2 s[16:17], s[0:1], 48
buffer_load_dwordx4 v13, s[12:15], s40 offen lds
s_add_u32 m0, s35, 28672
v_xor_b32 v4, s39, v4
buffer_load_dwordx4 v13, s[12:15], s41 offen lds
v_lshlrev_b32 v4, 6, v4
v_lshl_add_u32 v3, v3, 4, v4
s_lshr_b32 s30, s3, 1
s_add_u32 s30, s30, s25
v_mad_u32_u24 v5, v2, 6, s30
v_mad_u32_u24 v11, v5, s31, v3
v_cmp_eq_u32 vcc, 0, v5
v_mov_b32 v6, 0x7f000000
v_subrev_u32 v10, 1280, v11
v_add_u32 v12, 3840, v11
v_add_u32 v11, 1280, v11
v_cndmask_b32 v10, v10, v6, vcc
s_mov_b32 m0, s35
s_mov_b32 s28, 0x76543210
buffer_load_dwordx4 v10, s[8:11], s32 offen lds
s_add_u32 m0, s35, 4096
s_mov_b32 s29, 0x98
buffer_load_dwordx4 v11, s[8:11], s32 offen lds
s_add_u32 m0, s35, 8192
s_add_u32 s30, s30, 95
buffer_load_dwordx4 v12, s[8:11], s32 offen lds
s_add_u32 s52, s56, 4
s_add_u32 s53, s56, 5
s_xor_b32 s54, s52, s53
s_mul_i32 s54, s54, 17
s_mov_b32 s55, 0
s_lshl_b32 s52, s52, 2
s_lshl_b64 s[54:55], s[54:55], s52
s_xor_b64 s[28:29], s[28:29], s[54:55]
s_sub_u32 s52, s56, 1
s_xor_b32 s54, s52, s56
s_mul_i32 s54, s54, 17
s_lshl_b32 s52, s52, 2
s_lshl_b32 s54, s54, s52
s_cmp_eq_u32 s56, 0
s_cselect_b32 s54, 0, s54
s_xor_b32 s28, s28, s54
s_lshr_b64 s[28:29], s[28:29], 4
s_add_u32 m0, s35, 16384
s_and_b32 s30, s28, 15
buffer_load_dwordx4 v13, s[12:15], s34 offen lds
s_add_u32 m0, s35, 24576
s_add_u32 s40, s34, 819200
s_lshr_b64 s[28:29], s[28:29], 4
buffer_load_dwordx4 v13, s[12:15], s40 offen lds
s_add_u32 m0, s35, 32768
s_add_u32 s40, s34, 1638400
s_lshl_b32 s52, s30, 7
buffer_load_dwordx4 v13, s[12:15], s40 offen lds
s_mul_i32 s53, s30, 81920
s_add_u32 s54, s53, s38
s_add_u32 s53, s53, s37
s_add_u32 s55, s35, 36864
s_cmp_ge_u32 s55, 147456
s_cselect_b32 s55, s36, s55
s_mov_b64 s[32:33], s[52:53]
s_mov_b64 s[34:35], s[54:55]
s_add_u32 m0, s35, 0
s_nop 0
buffer_load_dwordx4 v10, s[8:11], s32 offen lds
s_add_u32 m0, s35, 4096
s_nop 0
buffer_load_dwordx4 v11, s[8:11], s32 offen lds
s_add_u32 m0, s35, 8192
s_nop 0
buffer_load_dwordx4 v12, s[8:11], s32 offen lds
s_add_u32 m0, s35, 12288
s_nop 0
buffer_load_dwordx4 v13, s[12:15], s33 offen lds
s_add_u32 m0, s35, 20480
s_add_u32 s40, s33, 819200
buffer_load_dwordx4 v13, s[12:15], s40 offen lds
s_add_u32 m0, s35, 28672
s_add_u32 s40, s33, 1638400
buffer_load_dwordx4 v13, s[12:15], s40 offen lds
s_waitcnt vmcnt(9)
s_barrier
s_add_u32 m0, s35, 16384
s_and_b32 s30, s28, 15
buffer_load_dwordx4 v13, s[12:15], s34 offen lds
s_add_u32 m0, s35, 24576
s_add_u32 s40, s34, 819200
s_lshr_b64 s[28:29], s[28:29], 4
buffer_load_dwordx4 v13, s[12:15], s40 offen lds
s_add_u32 m0, s35, 32768
s_add_u32 s40, s34, 1638400
s_lshl_b32 s52, s30, 7
buffer_load_dwordx4 v13, s[12:15], s40 offen lds
s_mul_i32 s53, s30, 81920
s_add_u32 s54, s53, s38
s_add_u32 s53, s53, s37
s_add_u32 s55, s35, 36864
s_cmp_ge_u32 s55, 147456
s_cselect_b32 s55, s36, s55
s_mov_b64 s[32:33], s[52:53]
s_mov_b64 s[34:35], s[54:55]
s_mov_b32 s42, 0
s_waitcnt vmcnt(9)
s_barrier
L_lloop:
s_add_u32 m0, s35, 0
s_and_b32 s30, s28, 15
buffer_load_dwordx4 v10, s[8:11], s32 offen lds
s_add_u32 m0, s35, 4096
s_lshr_b64 s[28:29], s[28:29], 4
buffer_load_dwordx4 v11, s[8:11], s32 offen lds
s_add_u32 m0, s35, 8192
s_lshl_b32 s52, s30, 7
buffer_load_dwordx4 v12, s[8:11], s32 offen lds
s_add_u32 m0, s35, 12288
s_mul_i32 s53, s30, 81920
buffer_load_dwordx4 v13, s[12:15], s33 offen lds
s_add_u32 m0, s35, 20480
s_add_u32 s40, s33, 819200
s_add_u32 s54, s53, s38
buffer_load_dwordx4 v13, s[12:15], s40 offen lds
s_add_u32 m0, s35, 28672
s_add_u32 s40, s33, 1638400
s_add_u32 s53, s53, s37
buffer_load_dwordx4 v13, s[12:15], s40 offen lds
s_add_u32 m0, s35, 16384
s_add_u32 s55, s35, 36864
buffer_load_dwordx4 v13, s[12:15], s34 offen lds
s_add_u32 m0, s35, 24576
s_add_u32 s40, s34, 819200
s_cmp_ge_u32 s55, 147456
s_cselect_b32 s55, s36, s55
buffer_load_dwordx4 v13, s[12:15], s40 offen lds
s_add_u32 m0, s35, 32768
s_add_u32 s40, s34, 1638400
buffer_load_dwordx4 v13, s[12:15], s40 offen lds
s_mov_b64 s[32:33], s[52:53]
s_mov_b64 s[34:35], s[54:55]
s_add_u32 s42, s42, 1
s_cmp_lt_u32 s42, 8
s_waitcnt vmcnt(9)
s_barrier
s_cbranch_scc1 L_lloop
s_waitcnt vmcnt(0) lgkmcnt(0)
s_barrier
s_mov_b32 s18, 2621440
s_mov_b32 s19, 0x20000
v_lshrrev_b32 v1, 3, v0
s_and_b32 s30, s3, 1
s_lshl_b32 s30, s30, 3
v_add_u32 v1, s30, v1
v_lshrrev_b32 v2, 1, v1
v_xor_b32 v2, v2, v0
v_and_b32 v2, 7, v2
v_lshl_add_u32 v2, v2, 4, s27
s_lshr_b32 s30, s3, 1
s_add_u32 s30, s30, s25
v_mad_u32_u24 v1, v1, 6, s30
v_mad_u32_u24 v1, v1, s31, v2
s_add_u32 s30, s36, 73728
v_lshl_add_u32 v2, v0, 4, s30
s_movk_i32 s40, 2560
s_movk_i32 s41, 5120
s_barrier
ds_read_b128 v[4:7], v2 offset:0
ds_read_b128 v[8:11], v2 offset:4096
s_waitcnt lgkmcnt(1)
buffer_store_dwordx4 v[4:7], v1, s[16:19], 0 offen sc1
s_waitcnt lgkmcnt(0)
buffer_store_dwordx4 v[8:11], v1, s[16:19], s40 offen sc1
L_end:
s_endpgm
L_pf:
s_cmp_lg_u32 s3, 0
s_cbranch_scc1 L_pfend
s_cmp_ge_u32 s2, 256
s_cbranch_scc1 L_pfend
s_sub_u32 s21, s21, s25
s_mul_i32 s21, s21, 111
s_mov_b32 s14, 2457600
s_mov_b32 s15, 0x20000
s_mov_b32 s10, 2621440
s_mov_b32 s11, 0x20000
s_cmp_eq_u32 s22, 3
s_cselect_b32 s24, 10, 0
s_sub_u32 s24, 259, s24
s_mul_i32 s26, s22, 517
s_and_b32 s23, s20, 1
s_mul_i32 s27, s23, s24
s_add_u32 s26, s26, s27
s_mul_i32 s27, s22, 296
s_sub_u32 s27, s27, 111
s_max_i32 s27, s27, 0
s_add_u32 s28, s22, 1
s_mul_i32 s28, s28, 296
s_sub_u32 s28, s28, 111
s_min_u32 s28, s28, 960
s_sub_u32 s27, s27, s24
s_mul_i32 s23, s23, 640
s_movk_i32 s29, 1280
v_mov_b32 v8, 0x7f000000
v_add_u32 v1, s21, v0
v_cmp_gt_u32 vcc, s24, v1
v_add_u32 v2, s26, v1
v_mul_lo_u32 v2, v2, s29
v_cndmask_b32 v4, v8, v2, vcc
v_add_u32 v1, s27, v1
v_cmp_gt_u32 s[30:31], s28, v1
v_mul_u32_u24 v2, 683, v1
v_lshrrev_b32 v2, 17, v2
v_mul_u32_u24 v3, 192, v2
v_sub_u32 v1, v1, v3
s_andn2_b64 vcc, s[30:31], vcc
v_lshl_add_u32 v2, v2, 7, s23
v_lshrrev_b32 v3, 6, v1
v_mul_u32_u24 v3, 576, v3
v_add_u32 v1, v1, v3
v_mad_u32_u24 v2, v1, s29, v2
v_cndmask_b32 v5, v8, v2, vcc
v_min_u32 v1, 46, v0
v_add_u32 v1, s21, v1
v_add_u32 v1, 64, v1
v_cmp_gt_u32 vcc, s24, v1
v_add_u32 v2, s26, v1
v_mul_lo_u32 v2, v2, s29
v_cndmask_b32 v6, v8, v2, vcc
v_add_u32 v1, s27, v1
v_cmp_gt_u32 s[30:31], s28, v1
v_mul_u32_u24 v2, 683, v1
v_lshrrev_b32 v2, 17, v2
v_mul_u32_u24 v3, 192, v2
v_sub_u32 v1, v1, v3
s_andn2_b64 vcc, s[30:31], vcc
v_lshl_add_u32 v2, v2, 7, s23
v_lshrrev_b32 v3, 6, v1
v_mul_u32_u24 v3, 576, v3
v_add_u32 v1, v1, v3
v_mad_u32_u24 v2, v1, s29, v2
v_cndmask_b32 v7, v8, v2, vcc
s_movk_i32 s26, 256
s_mov_b32 s27, 163840
s_waitcnt lgkmcnt(0)
s_mov_b32 s32, 81920
buffer_load_dword v3, v5, s[12:15], s32 offen
buffer_load_dword v3, v7, s[12:15], s32 offen
L_pfl:
buffer_load_dword v3, v4, s[8:11], s26 offen
buffer_load_dword v3, v5, s[12:15], s27 offen
buffer_load_dword v3, v6, s[8:11], s26 offen
buffer_load_dword v3, v7, s[12:15], s27 offen
s_add_u32 s27, s27, 81920
s_add_u32 s26, s26, 128
s_cmp_lt_u32 s26, 1280
s_cbranch_scc1 L_pfl
L_pfend:
s_endpgm
.p2align 12
L_cons:
s_sub_u32 s3, s3, 4
v_and_b32 v1, 15, v0
v_lshrrev_b32 v2, 4, v0
v_lshrrev_b32 v3, 1, v1
v_and_b32 v3, 4, v3
v_xor_b32 v1, v1, v3
v_lshlrev_b32 v3, 1, v2
v_and_b32 v3, 2, v3
v_lshrrev_b32 v11, 1, v2
v_or_b32 v3, v3, v11
v_lshrrev_b32 v11, 2, v1
v_xor_b32 v11, v11, v3
v_and_b32 v11, 3, v11
v_lshlrev_b32 v11, 4, v11
v_and_b32 v12, 7, v1
v_lshl_add_u32 v11, v12, 6, v11
v_lshrrev_b32 v12, 3, v1
v_lshl_add_u32 v7, v12, 10, v11
v_add_u32 v13, 1, v1
v_lshrrev_b32 v11, 2, v13
v_xor_b32 v11, v11, v3
v_and_b32 v11, 3, v11
v_lshlrev_b32 v11, 4, v11
v_and_b32 v12, 7, v13
v_lshl_add_u32 v11, v12, 6, v11
v_lshrrev_b32 v12, 3, v13
v_lshl_add_u32 v8, v12, 10, v11
v_bfe_u32 v11, v0, 2, 2
v_lshl_add_u32 v12, v3, 3, v11
v_and_b32 v11, 2, v11
v_lshlrev_b32 v13, 2, v2
v_and_b32 v13, 4, v13
v_or_b32 v11, v11, v13
v_bfe_u32 v13, v0, 1, 1
s_lshl_b32 s31, s3, 1
v_add_u32 v13, s31, v13
v_xor_b32 v11, v11, v13
v_lshlrev_b32 v11, 4, v11
v_lshl_add_u32 v11, v12, 7, v11
v_and_b32 v12, 1, v0
v_lshl_add_u32 v11, v12, 3, v11
v_add_u32 v9, 12288, v11
v_lshrrev_b32 v11, 1, v2
v_add_u32 v11, s31, v11
v_lshrrev_b32 v12, 1, v1
v_xor_b32 v11, v11, v12
v_lshlrev_b32 v11, 4, v11
v_lshl_add_u32 v11, v1, 7, v11
v_and_b32 v12, 1, v2
v_lshl_add_u32 v11, v12, 3, v11
v_add_u32 v14, 73728, v11
s_lshl_b32 s30, s3, 5
s_add_u32 s30, s30, 147456
v_lshl_add_u32 v15, v2, 3, s30
s_load_dwordx2 s[16:17], s[0:1], 48
s_mov_b32 s18, 2621440
s_mov_b32 s19, 0x20000
v_lshrrev_b32 v11, 3, v0
s_and_b32 s30, s3, 1
s_lshl_b32 s30, s30, 3
v_add_u32 v11, s30, v11
v_lshrrev_b32 v12, 1, v11
v_xor_b32 v12, v12, v0
v_and_b32 v12, 7, v12
v_lshl_add_u32 v12, v12, 4, s27
s_mul_i32 s25, s25, 94
s_lshr_b32 s30, s3, 1
s_add_u32 s30, s30, s25
s_add_u32 s30, s30, 4
s_movk_i32 s31, 1280
v_cmp_eq_u32 vcc, 15, v11
v_mov_b32 v13, 0x7f000000
v_mad_u32_u24 v11, v11, 6, s30
v_mad_u32_u24 v2, v11, s31, v12
v_cndmask_b32 v2, v2, v13, vcc
s_lshl_b32 s30, s3, 10
s_add_u32 s30, s30, 81920
v_lshl_add_u32 v3, v0, 4, s30
v_mov_b32 v16, 0
v_mov_b32 v17, 0
v_mov_b32 v18, 0
v_mov_b32 v19, 0
v_mov_b32 v20, 0
v_mov_b32 v21, 0
v_mov_b32 v22, 0
v_mov_b32 v23, 0
v_mov_b32 v24, 0
v_mov_b32 v25, 0
v_mov_b32 v26, 0
v_mov_b32 v27, 0
v_mov_b32 v28, 0
v_mov_b32 v29, 0
v_mov_b32 v30, 0
v_mov_b32 v31, 0
v_mov_b32 v32, 0
v_mov_b32 v33, 0
v_mov_b32 v34, 0
v_mov_b32 v35, 0
v_mov_b32 v36, 0
v_mov_b32 v37, 0
v_mov_b32 v38, 0
v_mov_b32 v39, 0
s_mov_b32 s32, 0
s_mov_b32 s39, 0
s_mov_b32 s34, 147456
s_mov_b32 s33, 147456
s_mov_b32 s42, 0x3fb8aa3b
s_mov_b32 s43, s42
s_mov_b32 s52, 0x3727c5ac
s_mov_b32 s53, s52
v_add_u32 v4, s32, v7
v_add_u32 v6, s32, v9
v_add_u32 v5, s32, v8
s_nop 0
s_waitcnt vmcnt(0) lgkmcnt(0)
s_barrier
ds_read_b64_tr_b16 v[72:73], v6 offset:0
ds_read_b64_tr_b16 v[74:75], v6 offset:512
ds_read_b128 v[40:43], v4 offset:0
ds_read_b64_tr_b16 v[76:77], v6 offset:8192
ds_read_b64_tr_b16 v[78:79], v6 offset:8704
ds_read_b128 v[44:47], v4 offset:2048
ds_read_b64_tr_b16 v[80:81], v6 offset:16384
ds_read_b64_tr_b16 v[82:83], v6 offset:16896
ds_read_b128 v[48:51], v4 offset:4096
ds_read_b128 v[52:55], v4 offset:6144
ds_read_b128 v[56:59], v4 offset:8192
ds_read_b128 v[60:63], v4 offset:10240
ds_read_b128 v[64:67], v5 offset:0
ds_read_b128 v[68:71], v5 offset:2048
s_waitcnt lgkmcnt(5)
v_mfma_f32_16x16x32_bf16 v[16:19], v[72:75], v[40:43], v[16:19]
ds_read_b64 v[104:105], v15 offset:0
v_mfma_f32_16x16x32_bf16 v[16:19], v[76:79], v[44:47], v[16:19]
ds_read_b64 v[106:107], v15 offset:128
v_mfma_f32_16x16x32_bf16 v[16:19], v[80:83], v[48:51], v[16:19]
ds_read_b64 v[108:109], v15 offset:256
v_mfma_f32_16x16x32_bf16 v[20:23], v[72:75], v[44:47], v[20:23]
ds_read_b64 v[110:111], v15 offset:384
s_barrier
v_mfma_f32_16x16x32_bf16 v[20:23], v[76:79], v[48:51], v[20:23]
ds_read_b64_tr_b16 v[84:85], v6 offset:4096
s_waitcnt lgkmcnt(8)
v_mfma_f32_16x16x32_bf16 v[20:23], v[80:83], v[52:55], v[20:23]
ds_read_b64_tr_b16 v[86:87], v6 offset:4608
s_waitcnt lgkmcnt(2)
v_mfma_f32_16x16x32_bf16 v[24:27], v[72:75], v[48:51], v[24:27]
s_add_u32 s39, s39, 1
v_lshlrev_b32 v116, 16, v106
v_and_b32 v117, 0xffff0000, v106
v_lshlrev_b32 v118, 16, v107
ds_read_b128 v[40:43], v4 offset:512
v_mfma_f32_16x16x32_bf16 v[24:27], v[76:79], v[52:55], v[24:27]
v_and_b32 v119, 0xffff0000, v107
v_pk_add_f32 v[116:117], v[116:117], s[52:53]
v_pk_add_f32 v[118:119], v[118:119], s[52:53]
ds_read_b64_tr_b16 v[88:89], v6 offset:12288
v_mfma_f32_16x16x32_bf16 v[24:27], v[80:83], v[56:59], v[24:27]
v_lshlrev_b32 v120, 16, v108
v_and_b32 v121, 0xffff0000, v108
v_lshlrev_b32 v122, 16, v109
ds_read_b64_tr_b16 v[90:91], v6 offset:12800
v_mfma_f32_16x16x32_bf16 v[28:31], v[72:75], v[52:55], v[28:31]
s_add_u32 s32, s32, 36864
v_and_b32 v123, 0xffff0000, v109
v_rsq_f32 v116, v116
v_rsq_f32 v117, v117
ds_read_b128 v[44:47], v4 offset:2560
v_mfma_f32_16x16x32_bf16 v[28:31], v[76:79], v[56:59], v[28:31]
s_cmp_eq_u32 s32, 147456
s_cselect_b32 s32, 0, s32
v_rsq_f32 v118, v118
v_rsq_f32 v119, v119
v_pk_mul_f32 v[120:121], v[120:121], s[42:43]
ds_read_b64_tr_b16 v[92:93], v6 offset:20480
v_mfma_f32_16x16x32_bf16 v[28:31], v[80:83], v[60:63], v[28:31]
v_pk_mul_f32 v[122:123], v[122:123], s[42:43]
v_lshlrev_b32 v124, 16, v110
v_and_b32 v125, 0xffff0000, v110
ds_read_b64_tr_b16 v[94:95], v6 offset:20992
v_mfma_f32_16x16x32_bf16 v[32:35], v[72:75], v[56:59], v[32:35]
v_lshlrev_b32 v126, 16, v111
v_and_b32 v127, 0xffff0000, v111
ds_read_b128 v[48:51], v4 offset:4608
v_mfma_f32_16x16x32_bf16 v[32:35], v[76:79], v[60:63], v[32:35]
v_pk_mul_f32 v[96:97], v[120:121], v[116:117]
v_pk_mul_f32 v[98:99], v[122:123], v[118:119]
ds_read_b128 v[52:55], v4 offset:6656
v_mfma_f32_16x16x32_bf16 v[32:35], v[80:83], v[64:67], v[32:35]
v_pk_mul_f32 v[124:125], v[124:125], s[42:43]
v_pk_mul_f32 v[126:127], v[126:127], s[42:43]
ds_read_b128 v[56:59], v4 offset:8704
v_mfma_f32_16x16x32_bf16 v[36:39], v[72:75], v[60:63], v[36:39]
v_lshlrev_b32 v112, 16, v104
v_and_b32 v113, 0xffff0000, v104
ds_read_b128 v[60:63], v4 offset:10752
v_mfma_f32_16x16x32_bf16 v[36:39], v[76:79], v[64:67], v[36:39]
v_lshlrev_b32 v114, 16, v105
v_and_b32 v115, 0xffff0000, v105
ds_read_b128 v[64:67], v5 offset:512
v_mfma_f32_16x16x32_bf16 v[36:39], v[80:83], v[68:71], v[36:39]
v_pk_fma_f32 v[100:101], v[112:113], v[96:97], v[124:125] neg_lo:[1,0,0] neg_hi:[1,0,0]
v_pk_fma_f32 v[102:103], v[114:115], v[98:99], v[126:127] neg_lo:[1,0,0] neg_hi:[1,0,0]
ds_read_b128 v[68:71], v5 offset:2560
.p2align 3
L_cloop:
s_waitcnt lgkmcnt(5)
v_mfma_f32_16x16x32_bf16 v[16:19], v[84:87], v[40:43], v[16:19]
v_add_u32 v4, s32, v7
v_mfma_f32_16x16x32_bf16 v[16:19], v[88:91], v[44:47], v[16:19]
v_add_u32 v6, s32, v9
v_add_u32 v5, s32, v8
v_mfma_f32_16x16x32_bf16 v[16:19], v[92:95], v[48:51], v[16:19]
v_mfma_f32_16x16x32_bf16 v[20:23], v[84:87], v[44:47], v[20:23]
s_barrier
v_mfma_f32_16x16x32_bf16 v[20:23], v[88:91], v[48:51], v[20:23]
ds_read_b64_tr_b16 v[72:73], v6 offset:0
s_waitcnt lgkmcnt(1)
v_mfma_f32_16x16x32_bf16 v[20:23], v[92:95], v[52:55], v[20:23]
ds_read_b64_tr_b16 v[74:75], v6 offset:512
v_mfma_f32_16x16x32_bf16 v[24:27], v[84:87], v[48:51], v[24:27]
ds_read_b128 v[40:43], v4 offset:0
v_mfma_f32_16x16x32_bf16 v[24:27], v[88:91], v[52:55], v[24:27]
ds_read_b64_tr_b16 v[76:77], v6 offset:8192
v_mfma_f32_16x16x32_bf16 v[24:27], v[92:95], v[56:59], v[24:27]
ds_read_b64_tr_b16 v[78:79], v6 offset:8704
v_mfma_f32_16x16x32_bf16 v[28:31], v[84:87], v[52:55], v[28:31]
ds_read_b128 v[44:47], v4 offset:2048
v_mfma_f32_16x16x32_bf16 v[28:31], v[88:91], v[56:59], v[28:31]
ds_read_b64_tr_b16 v[80:81], v6 offset:16384
v_mfma_f32_16x16x32_bf16 v[28:31], v[92:95], v[60:63], v[28:31]
ds_read_b64_tr_b16 v[82:83], v6 offset:16896
v_mfma_f32_16x16x32_bf16 v[32:35], v[84:87], v[56:59], v[32:35]
ds_read_b128 v[48:51], v4 offset:4096
v_mfma_f32_16x16x32_bf16 v[32:35], v[88:91], v[60:63], v[32:35]
ds_read_b128 v[52:55], v4 offset:6144
v_mfma_f32_16x16x32_bf16 v[32:35], v[92:95], v[64:67], v[32:35]
ds_read_b128 v[56:59], v4 offset:8192
v_mfma_f32_16x16x32_bf16 v[36:39], v[84:87], v[60:63], v[36:39]
ds_read_b128 v[60:63], v4 offset:10240
v_mfma_f32_16x16x32_bf16 v[36:39], v[88:91], v[64:67], v[36:39]
ds_read_b128 v[64:67], v5 offset:0
v_mfma_f32_16x16x32_bf16 v[36:39], v[92:95], v[68:71], v[36:39]
ds_read_b128 v[68:71], v5 offset:2048
s_waitcnt lgkmcnt(5)
v_mfma_f32_16x16x32_bf16 v[16:19], v[72:75], v[40:43], v[16:19]
v_mfma_f32_16x16x32_bf16 v[16:19], v[76:79], v[44:47], v[16:19]
v_mfma_f32_16x16x32_bf16 v[16:19], v[80:83], v[48:51], v[16:19]
v_mfma_f32_16x16x32_bf16 v[20:23], v[72:75], v[44:47], v[20:23]
v_mfma_f32_16x16x32_bf16 v[20:23], v[76:79], v[48:51], v[20:23]
ds_read_b64_tr_b16 v[84:85], v6 offset:4096
s_waitcnt lgkmcnt(1)
v_mfma_f32_16x16x32_bf16 v[20:23], v[80:83], v[52:55], v[20:23]
ds_read_b64_tr_b16 v[86:87], v6 offset:4608
v_mfma_f32_16x16x32_bf16 v[24:27], v[72:75], v[48:51], v[24:27]
s_add_u32 s39, s39, 1
ds_read_b128 v[40:43], v4 offset:512
v_mfma_f32_16x16x32_bf16 v[24:27], v[76:79], v[52:55], v[24:27]
ds_read_b64_tr_b16 v[88:89], v6 offset:12288
v_mfma_f32_16x16x32_bf16 v[24:27], v[80:83], v[56:59], v[24:27]
ds_read_b64_tr_b16 v[90:91], v6 offset:12800
v_mfma_f32_16x16x32_bf16 v[28:31], v[72:75], v[52:55], v[28:31]
s_add_u32 s32, s32, 36864
ds_read_b128 v[44:47], v4 offset:2560
v_mfma_f32_16x16x32_bf16 v[28:31], v[76:79], v[56:59], v[28:31]
s_cmp_eq_u32 s32, 147456
s_cselect_b32 s32, 0, s32
ds_read_b64_tr_b16 v[92:93], v6 offset:20480
v_mfma_f32_16x16x32_bf16 v[28:31], v[80:83], v[60:63], v[28:31]
ds_read_b64_tr_b16 v[94:95], v6 offset:20992
v_mfma_f32_16x16x32_bf16 v[32:35], v[72:75], v[56:59], v[32:35]
ds_read_b128 v[48:51], v4 offset:4608
v_mfma_f32_16x16x32_bf16 v[32:35], v[76:79], v[60:63], v[32:35]
ds_read_b128 v[52:55], v4 offset:6656
v_mfma_f32_16x16x32_bf16 v[32:35], v[80:83], v[64:67], v[32:35]
s_cmp_lt_u32 s39, 9
ds_read_b128 v[56:59], v4 offset:8704
v_mfma_f32_16x16x32_bf16 v[36:39], v[72:75], v[60:63], v[36:39]
ds_read_b128 v[60:63], v4 offset:10752
v_mfma_f32_16x16x32_bf16 v[36:39], v[76:79], v[64:67], v[36:39]
ds_read_b128 v[64:67], v5 offset:512
v_mfma_f32_16x16x32_bf16 v[36:39], v[80:83], v[68:71], v[36:39]
ds_read_b128 v[68:71], v5 offset:2560
s_cbranch_scc1 L_cloop
s_waitcnt lgkmcnt(5)
v_mfma_f32_16x16x32_bf16 v[16:19], v[84:87], v[40:43], v[16:19]
v_add_u32 v6, s32, v9
v_add_u32 v4, s32, v7
s_barrier
v_mfma_f32_16x16x32_bf16 v[16:19], v[88:91], v[44:47], v[16:19]
ds_read_b64_tr_b16 v[72:73], v6 offset:0
ds_read_b64_tr_b16 v[74:75], v6 offset:512
v_mfma_f32_16x16x32_bf16 v[16:19], v[92:95], v[48:51], v[16:19]
ds_read_b128 v[128:131], v4 offset:0
ds_read_b64_tr_b16 v[76:77], v6 offset:8192
v_mfma_f32_16x16x32_bf16 v[20:23], v[84:87], v[44:47], v[20:23]
ds_read_b64_tr_b16 v[78:79], v6 offset:8704
ds_read_b128 v[132:135], v4 offset:2048
v_mfma_f32_16x16x32_bf16 v[20:23], v[88:91], v[48:51], v[20:23]
ds_read_b64_tr_b16 v[80:81], v6 offset:16384
s_waitcnt lgkmcnt(7)
v_mfma_f32_16x16x32_bf16 v[20:23], v[92:95], v[52:55], v[20:23]
ds_read_b64_tr_b16 v[82:83], v6 offset:16896
v_mfma_f32_16x16x32_bf16 v[24:27], v[84:87], v[48:51], v[24:27]
ds_read_b128 v[136:139], v4 offset:4096
v_mfma_f32_16x16x32_bf16 v[24:27], v[88:91], v[52:55], v[24:27]
ds_read_b128 v[140:143], v4 offset:6144
v_mfma_f32_16x16x32_bf16 v[24:27], v[92:95], v[56:59], v[24:27]
ds_read_b128 v[144:147], v4 offset:8192
s_waitcnt lgkmcnt(5)
v_mfma_f32_16x16x32_bf16 v[16:19], v[72:75], v[128:131], v[16:19]
ds_read_b64_tr_b16 v[192:193], v6 offset:4096
v_mfma_f32_16x16x32_bf16 v[16:19], v[76:79], v[132:135], v[16:19]
ds_read_b64_tr_b16 v[194:195], v6 offset:4608
ds_read_b128 v[160:163], v4 offset:512
s_waitcnt lgkmcnt(5)
v_mfma_f32_16x16x32_bf16 v[16:19], v[80:83], v[136:139], v[16:19]
ds_read_b64_tr_b16 v[196:197], v6 offset:12288
ds_read_b64_tr_b16 v[198:199], v6 offset:12800
v_mfma_f32_16x16x32_bf16 v[20:23], v[72:75], v[132:135], v[20:23]
v_add_u32 v5, s32, v8
ds_read_b128 v[164:167], v4 offset:2560
v_mfma_f32_16x16x32_bf16 v[20:23], v[76:79], v[136:139], v[20:23]
ds_read_b64_tr_b16 v[200:201], v6 offset:20480
s_waitcnt lgkmcnt(7)
v_mfma_f32_16x16x32_bf16 v[20:23], v[80:83], v[140:143], v[20:23]
ds_read_b64_tr_b16 v[202:203], v6 offset:20992
v_mfma_f32_16x16x32_bf16 v[24:27], v[72:75], v[136:139], v[24:27]
ds_read_b128 v[168:171], v4 offset:4608
v_mfma_f32_16x16x32_bf16 v[24:27], v[76:79], v[140:143], v[24:27]
ds_read_b128 v[172:175], v4 offset:6656
v_mfma_f32_16x16x32_bf16 v[24:27], v[80:83], v[144:147], v[24:27]
ds_read_b128 v[176:179], v4 offset:8704
s_waitcnt lgkmcnt(5)
v_mfma_f32_16x16x32_bf16 v[16:19], v[192:195], v[160:163], v[16:19]
ds_read_b128 v[148:151], v4 offset:10240
v_mfma_f32_16x16x32_bf16 v[16:19], v[196:199], v[164:167], v[16:19]
ds_read_b128 v[152:155], v5 offset:0
s_waitcnt lgkmcnt(4)
v_mfma_f32_16x16x32_bf16 v[16:19], v[200:203], v[168:171], v[16:19]
ds_read_b128 v[156:159], v5 offset:2048
v_mfma_f32_16x16x32_bf16 v[20:23], v[192:195], v[164:167], v[20:23]
ds_read_b128 v[180:183], v4 offset:10752
v_mfma_f32_16x16x32_bf16 v[20:23], v[196:199], v[168:171], v[20:23]
ds_read_b128 v[184:187], v5 offset:512
s_waitcnt lgkmcnt(5)
v_mfma_f32_16x16x32_bf16 v[20:23], v[200:203], v[172:175], v[20:23]
ds_read_b128 v[188:191], v5 offset:2560
v_mfma_f32_16x16x32_bf16 v[24:27], v[192:195], v[168:171], v[24:27]
v_fma_f32 v108, v16, v96, v100
v_fma_f32 v109, v17, v97, v101
v_mfma_f32_16x16x32_bf16 v[24:27], v[196:199], v[172:175], v[24:27]
v_fma_f32 v110, v18, v98, v102
v_fma_f32 v111, v19, v99, v103
v_mfma_f32_16x16x32_bf16 v[24:27], v[200:203], v[176:179], v[24:27]
v_exp_f32 v104, -v108
v_mfma_f32_16x16x32_bf16 v[28:31], v[84:87], v[52:55], v[28:31]
v_exp_f32 v105, -v109
v_mfma_f32_16x16x32_bf16 v[28:31], v[88:91], v[56:59], v[28:31]
v_exp_f32 v106, -v110
v_mfma_f32_16x16x32_bf16 v[28:31], v[92:95], v[60:63], v[28:31]
v_exp_f32 v107, -v111
v_mfma_f32_16x16x32_bf16 v[32:35], v[84:87], v[56:59], v[32:35]
v_fma_f32 v104, v104, s42, s42
v_fma_f32 v105, v105, s42, s42
v_mfma_f32_16x16x32_bf16 v[32:35], v[88:91], v[60:63], v[32:35]
v_fma_f32 v106, v106, s42, s42
v_fma_f32 v107, v107, s42, s42
v_mfma_f32_16x16x32_bf16 v[32:35], v[92:95], v[64:67], v[32:35]
v_rcp_f32 v104, v104
v_mfma_f32_16x16x32_bf16 v[36:39], v[84:87], v[60:63], v[36:39]
v_rcp_f32 v105, v105
v_mfma_f32_16x16x32_bf16 v[36:39], v[88:91], v[64:67], v[36:39]
v_rcp_f32 v106, v106
v_mfma_f32_16x16x32_bf16 v[36:39], v[92:95], v[68:71], v[36:39]
v_rcp_f32 v107, v107
v_mfma_f32_16x16x32_bf16 v[28:31], v[72:75], v[140:143], v[28:31]
v_mul_f32 v108, v108, v104
v_mul_f32 v109, v109, v105
v_mfma_f32_16x16x32_bf16 v[28:31], v[76:79], v[144:147], v[28:31]
v_mul_f32 v110, v110, v106
v_mul_f32 v111, v111, v107
s_waitcnt lgkmcnt(0)
v_mfma_f32_16x16x32_bf16 v[28:31], v[80:83], v[148:151], v[28:31]
v_cvt_pk_bf16_f32 v112, v108, v109
v_cvt_pk_bf16_f32 v113, v110, v111
v_mfma_f32_16x16x32_bf16 v[32:35], v[72:75], v[144:147], v[32:35]
v_fma_f32 v118, v20, v96, v100
v_fma_f32 v119, v21, v97, v101
v_mfma_f32_16x16x32_bf16 v[32:35], v[76:79], v[148:151], v[32:35]
v_fma_f32 v120, v22, v98, v102
v_fma_f32 v121, v23, v99, v103
v_mfma_f32_16x16x32_bf16 v[32:35], v[80:83], v[152:155], v[32:35]
v_exp_f32 v114, -v118
v_mfma_f32_16x16x32_bf16 v[36:39], v[72:75], v[148:151], v[36:39]
v_exp_f32 v115, -v119
v_mfma_f32_16x16x32_bf16 v[36:39], v[76:79], v[152:155], v[36:39]
v_exp_f32 v116, -v120
v_mfma_f32_16x16x32_bf16 v[36:39], v[80:83], v[156:159], v[36:39]
v_exp_f32 v117, -v121
v_mfma_f32_16x16x32_bf16 v[28:31], v[192:195], v[172:175], v[28:31]
v_fma_f32 v114, v114, s42, s42
v_fma_f32 v115, v115, s42, s42
v_mfma_f32_16x16x32_bf16 v[28:31], v[196:199], v[176:179], v[28:31]
v_fma_f32 v116, v116, s42, s42
v_fma_f32 v117, v117, s42, s42
v_mfma_f32_16x16x32_bf16 v[28:31], v[200:203], v[180:183], v[28:31]
v_rcp_f32 v114, v114
v_mfma_f32_16x16x32_bf16 v[32:35], v[192:195], v[176:179], v[32:35]
v_rcp_f32 v115, v115
v_mfma_f32_16x16x32_bf16 v[32:35], v[196:199], v[180:183], v[32:35]
v_rcp_f32 v116, v116
v_mfma_f32_16x16x32_bf16 v[32:35], v[200:203], v[184:187], v[32:35]
v_rcp_f32 v117, v117
v_mfma_f32_16x16x32_bf16 v[36:39], v[192:195], v[180:183], v[36:39]
v_mul_f32 v118, v118, v114
v_mul_f32 v119, v119, v115
v_mfma_f32_16x16x32_bf16 v[36:39], v[196:199], v[184:187], v[36:39]
ds_write_b64 v14, v[112:113] offset:0
v_cvt_pk_bf16_f32 v122, v118, v119
v_mfma_f32_16x16x32_bf16 v[36:39], v[200:203], v[188:191], v[36:39]
v_mul_f32 v120, v120, v116
v_mul_f32 v121, v121, v117
v_pk_fma_f32 v[108:109], v[24:25], v[96:97], v[100:101]
v_cvt_pk_bf16_f32 v123, v120, v121
v_pk_fma_f32 v[110:111], v[26:27], v[98:99], v[102:103]
ds_write_b64 v14, v[122:123] offset:2048
v_exp_f32 v104, -v108
v_exp_f32 v105, -v109
v_exp_f32 v106, -v110
v_exp_f32 v107, -v111
v_pk_fma_f32 v[104:105], v[104:105], s[42:43], s[42:43]
v_pk_fma_f32 v[106:107], v[106:107], s[42:43], s[42:43]
v_rcp_f32 v104, v104
v_rcp_f32 v105, v105
v_rcp_f32 v106, v106
v_rcp_f32 v107, v107
v_pk_mul_f32 v[108:109], v[108:109], v[104:105]
v_pk_mul_f32 v[110:111], v[110:111], v[106:107]
v_cvt_pk_bf16_f32 v112, v108, v109
v_cvt_pk_bf16_f32 v113, v110, v111
v_pk_fma_f32 v[118:119], v[28:29], v[96:97], v[100:101]
ds_write_b64 v14, v[112:113] offset:4096
v_pk_fma_f32 v[120:121], v[30:31], v[98:99], v[102:103]
v_exp_f32 v114, -v118
v_exp_f32 v115, -v119
v_exp_f32 v116, -v120
v_exp_f32 v117, -v121
v_pk_fma_f32 v[114:115], v[114:115], s[42:43], s[42:43]
v_pk_fma_f32 v[116:117], v[116:117], s[42:43], s[42:43]
v_rcp_f32 v114, v114
v_rcp_f32 v115, v115
v_rcp_f32 v116, v116
v_rcp_f32 v117, v117
v_pk_mul_f32 v[118:119], v[118:119], v[114:115]
v_pk_mul_f32 v[120:121], v[120:121], v[116:117]
v_cvt_pk_bf16_f32 v122, v118, v119
v_cvt_pk_bf16_f32 v123, v120, v121
v_pk_fma_f32 v[108:109], v[32:33], v[96:97], v[100:101]
ds_write_b64 v14, v[122:123] offset:6144
v_pk_fma_f32 v[110:111], v[34:35], v[98:99], v[102:103]
v_exp_f32 v104, -v108
v_exp_f32 v105, -v109
v_exp_f32 v106, -v110
v_exp_f32 v107, -v111
v_pk_fma_f32 v[104:105], v[104:105], s[42:43], s[42:43]
v_pk_fma_f32 v[106:107], v[106:107], s[42:43], s[42:43]
v_rcp_f32 v104, v104
v_rcp_f32 v105, v105
v_rcp_f32 v106, v106
v_rcp_f32 v107, v107
v_pk_mul_f32 v[108:109], v[108:109], v[104:105]
v_pk_mul_f32 v[110:111], v[110:111], v[106:107]
v_cvt_pk_bf16_f32 v112, v108, v109
v_cvt_pk_bf16_f32 v113, v110, v111
v_pk_fma_f32 v[118:119], v[36:37], v[96:97], v[100:101]
ds_write_b64 v14, v[112:113] offset:8192
v_pk_fma_f32 v[120:121], v[38:39], v[98:99], v[102:103]
v_exp_f32 v114, -v118
v_exp_f32 v115, -v119
v_exp_f32 v116, -v120
v_exp_f32 v117, -v121
v_pk_fma_f32 v[114:115], v[114:115], s[42:43], s[42:43]
v_pk_fma_f32 v[116:117], v[116:117], s[42:43], s[42:43]
v_rcp_f32 v114, v114
v_rcp_f32 v115, v115
v_rcp_f32 v116, v116
v_rcp_f32 v117, v117
v_pk_mul_f32 v[118:119], v[118:119], v[114:115]
v_pk_mul_f32 v[120:121], v[120:121], v[116:117]
v_cvt_pk_bf16_f32 v122, v118, v119
v_cvt_pk_bf16_f32 v123, v120, v121
s_nop 0
ds_write_b64 v14, v[122:123] offset:10240
s_waitcnt lgkmcnt(0)
s_barrier
ds_read_b128 v[40:43], v3
s_waitcnt lgkmcnt(0)
buffer_store_dwordx4 v[40:43], v2, s[16:19], 0 offen sc1
s_endpgm
.section .rodata,"a"
.p2align 6
.amdhsa_kernel standalone__batchnorm__prompt_kernel
  .amdhsa_next_free_vgpr 204
  .amdhsa_next_free_sgpr 100
  .amdhsa_accum_offset 204
  .amdhsa_group_segment_fixed_size 0
  .amdhsa_kernarg_size 72
  .amdhsa_user_sgpr_count 2
  .amdhsa_user_sgpr_kernarg_segment_ptr 1
  .amdhsa_system_sgpr_workgroup_id_x 1
.end_amdhsa_kernel
```
